```python
import torch

def _softmax(x, axis=-1):
    return torch.softmax(x, dim=axis)
def _gelu(x):
    return torch.nn.functional.gelu(x, approximate="tanh")
def _silu(x):
    return torch.nn.functional.silu(x)
def _sigmoid(x):
    return torch.sigmoid(x)
def _layernorm(x, axis=-1, eps=1e-5):
    m = x.mean(dim=axis, keepdim=True)
    v = x.var(dim=axis, keepdim=True, unbiased=False)
    return (x - m) / torch.sqrt(v + eps)
def _scatter_add(tgt, idx, src, axis=0):
    return tgt.clone().index_add_(axis, idx, src)
def _segment_sum(src, seg, n):
    out = torch.zeros((n,) + src.shape[1:], dtype=src.dtype)
    return out.index_add_(0, seg, src)
def _pad(x, pw):
    flat = tuple(v for pair in reversed(pw) for v in pair)
    return torch.nn.functional.pad(x, flat)

kernel_name = 'standalone__low_rank_proj_linformer__sampling'

def setup_inputs():

    _w = (lambda a: (lambda t: t.to(torch.bfloat16) if t.is_floating_point() else t)(torch.as_tensor(a)))
    B, H, Sq, Skv, Dh, R = 8, 32, 8, 2048, 192, 16
    return {
        "q": _w((lambda *s: torch.randn(*s, dtype=torch.bfloat16) * 0.8)(B, H, Sq, Dh)),
        "k": _w((lambda *s: torch.randn(*s, dtype=torch.bfloat16) * 0.8)(B, H, Skv, Dh)),
        "v": _w((lambda *s: torch.randn(*s, dtype=torch.bfloat16) * 0.05)(B, H, Skv, Dh)),
        "e_proj": _w((lambda *s: torch.randn(*s, dtype=torch.bfloat16) * 0.8)(R, Skv) * (Skv ** -0.5)),
        "f_proj": _w((lambda *s: torch.randn(*s, dtype=torch.bfloat16) * 0.05)(R, Skv) * (Skv ** -0.5)),
    }

def reference(q, k, v, e_proj, f_proj):
    B, H, Sq, Dh = q.shape
    kp = torch.einsum("rn,bhnd->bhrd", e_proj, k)
    vp = torch.einsum("rn,bhnd->bhrd", f_proj, v)
    scores = torch.einsum("bhqd,bhrd->bhqr", q, kp) * (Dh ** -0.5)
    p = _softmax(scores, axis=-1)
    o = torch.einsum("bhqr,bhrd->bhqd", p, vp)
    return o
```

```asm
; @launch grid=(256,1,1) block=(320,1,1) lds=162320
.amdgcn_target "amdgcn-amd-amdhsa--gfx950"
.text
.globl standalone__low_rank_proj_linformer__sampling_kernel
.p2align 8
.type standalone__low_rank_proj_linformer__sampling_kernel,@function
standalone__low_rank_proj_linformer__sampling_kernel:
    s_load_dwordx8 s[4:11], s[0:1], 0
    s_getpc_b64 s[20:21]
    v_subrev_u32 v3, 64, v0
    v_cmp_gt_u32 vcc, 24, v3
    v_lshlrev_b32 v4, 7, v3
    v_mov_b32 v5, 0
    s_and_saveexec_b64 s[22:23], vcc
    s_cbranch_execz L_nopf
    v_lshl_add_u64 v[4:5], v[4:5], 0, s[20:21]
    global_load_dword v63, v[4:5], off
L_nopf:
    s_mov_b64 exec, s[22:23]
    v_readfirstlane_b32 s3, v0
    v_and_b32 v2, 48, v0
    v_lshlrev_b32 v1, 3, v0
    s_load_dwordx4 s[12:15], s[0:1], 32
    s_cmp_ge_u32 s2, 0x100
    s_cbranch_scc1 L_end
    s_mul_i32 s32, s2, 786432
    s_cmp_lg_u32 s3, 0
    s_cbranch_scc1 L_cons
    v_xor_b32 v1, v1, v2
    s_mov_b32 s18, 786432
    v_lshlrev_b32 v1, 1, v1
    s_mov_b32 s19, 0x20000
    s_movk_i32 s41, 0x1000
    s_lshl_b32 s42, s41, 3
    s_mov_b32 m0, 0
    s_waitcnt lgkmcnt(0)
    s_add_u32 s16, s6, s32
    s_addc_u32 s17, s7, 0
L_first:
    buffer_load_dwordx4 v1, s[16:19], m0 offen nt lds
    s_xor_b32 m0, m0, s41
    s_nop 0
    buffer_load_dwordx4 v1, s[16:19], m0 offen nt lds
    s_xor_b32 m0, m0, s42
    s_nop 0
    buffer_load_dwordx4 v1, s[16:19], m0 offen nt lds
    s_xor_b32 m0, m0, s41
    s_nop 0
    buffer_load_dwordx4 v1, s[16:19], m0 offen nt lds
    s_xor_b32 m0, m0, s42
    s_addk_i32 m0, 0x400
    s_cmp_lg_u32 m0, s41
    s_cbranch_scc1 L_first
    s_mov_b32 s35, 1
    s_movk_i32 s40, 0x2000
    s_movk_i32 s41, 0x3000
    s_add_u32 s43, s42, s41
    s_add_u32 s42, s42, s40
    s_mov_b64 s[44:45], s[40:41]
    s_mov_b64 s[46:47], s[42:43]
    s_mov_b32 s50, 0x00c0000f
    s_mov_b32 s48, 0x400005
    v_mov_b32 v2, 159232
    v_mov_b32 v3, 0x400005
    v_mov_b32 v4, v1
    ds_write_b32 v2, v3
L_lgrp:
    s_mov_b32 s49, 0
    v_mov_b32 v1, v4
L_lquad:
    s_add_u32 m0, s44, s49
L_poll0:
    s_getreg_b32 s51, hwreg(HW_REG_IB_STS)
    s_and_b32 s51, s51, s50
    s_cmp_ge_u32 s51, s48
    s_cbranch_scc1 L_poll0
    buffer_load_dwordx4 v1, s[16:19], s40 offen nt lds
    s_add_u32 m0, s45, s49
L_poll1:
    s_getreg_b32 s51, hwreg(HW_REG_IB_STS)
    s_and_b32 s51, s51, s50
    s_cmp_ge_u32 s51, s48
    s_cbranch_scc1 L_poll1
    buffer_load_dwordx4 v1, s[16:19], s41 offen nt lds
    s_add_u32 m0, s46, s49
L_poll2:
    s_getreg_b32 s51, hwreg(HW_REG_IB_STS)
    s_and_b32 s51, s51, s50
    s_cmp_ge_u32 s51, s48
    s_cbranch_scc1 L_poll2
    buffer_load_dwordx4 v1, s[16:19], s42 offen nt lds
    s_add_u32 m0, s47, s49
L_poll3:
    s_getreg_b32 s51, hwreg(HW_REG_IB_STS)
    s_and_b32 s51, s51, s50
    s_cmp_ge_u32 s51, s48
    s_cbranch_scc1 L_poll3
    buffer_load_dwordx4 v1, s[16:19], s43 offen nt lds
    v_add_u32 v1, 0x400, v1
    s_addk_i32 s49, 0x400
    s_cmpk_eq_u32 s49, 0x1000
    s_cbranch_scc1 L_lgend
    s_cmpk_lg_u32 s49, 0x800
    s_cbranch_scc1 L_lquad
    ds_read_b32 v3, v2
    s_cmp_lt_u32 s35, 2
    s_cbranch_scc1 L_lquad
    s_waitcnt vmcnt(24)
    s_barrier
    s_branch L_lquad
L_lgend:
    s_add_u32 s35, s35, 1
    s_and_b32 s36, s35, 3
    s_cselect_b32 s36, 8, 40
    s_lshl_b32 s36, s36, 10
    s_waitcnt lgkmcnt(0)
    v_readfirstlane_b32 s48, v3
    s_add_u32 s40, s40, s36
    s_add_u32 s44, s44, s36
    s_sub_u32 s37, s44, 122880
    s_cselect_b32 s44, s44, s37
    s_add_u32 s41, s41, s36
    s_add_u32 s45, s45, s36
    s_sub_u32 s37, s45, 122880
    s_cselect_b32 s45, s45, s37
    s_add_u32 s42, s42, s36
    s_add_u32 s46, s46, s36
    s_sub_u32 s37, s46, 122880
    s_cselect_b32 s46, s46, s37
    s_add_u32 s43, s43, s36
    s_add_u32 s47, s47, s36
    s_sub_u32 s37, s47, 122880
    s_cselect_b32 s47, s47, s37
    s_cmp_eq_u32 s35, 48
    s_cbranch_scc1 L_lswitch
    s_cmp_lt_u32 s35, 95
    s_cbranch_scc1 L_lgrp
    v_mov_b32 v1, v4
    s_mov_b32 m0, s44
    s_waitcnt vmcnt(31)
    buffer_load_dwordx4 v1, s[16:19], s40 offen offset:0 nt lds
    s_mov_b32 m0, s44
    s_waitcnt vmcnt(31)
    buffer_load_dwordx4 v1, s[16:19], s40 offen offset:1024 nt lds
    s_mov_b32 m0, s44
    s_waitcnt vmcnt(31)
    buffer_load_dwordx4 v1, s[16:19], s40 offen offset:2048 nt lds
    s_mov_b32 m0, s44
    s_waitcnt vmcnt(31)
    buffer_load_dwordx4 v1, s[16:19], s40 offen offset:3072 nt lds
    s_mov_b32 m0, s45
    s_waitcnt vmcnt(31)
    buffer_load_dwordx4 v1, s[16:19], s41 offen offset:0 nt lds
    s_mov_b32 m0, s45
    s_waitcnt vmcnt(31)
    buffer_load_dwordx4 v1, s[16:19], s41 offen offset:1024 nt lds
    s_mov_b32 m0, s45
    s_waitcnt vmcnt(31)
    buffer_load_dwordx4 v1, s[16:19], s41 offen offset:2048 nt lds
    s_mov_b32 m0, s45
    s_waitcnt vmcnt(31)
    buffer_load_dwordx4 v1, s[16:19], s41 offen offset:3072 nt lds
    s_mov_b32 m0, s46
    s_waitcnt vmcnt(24)
    s_barrier
    buffer_load_dwordx4 v1, s[16:19], s42 offen offset:0 nt lds
    s_mov_b32 m0, s47
    s_waitcnt vmcnt(31)
    buffer_load_dwordx4 v1, s[16:19], s43 offen offset:0 nt lds
    s_mov_b32 m0, s46
    s_waitcnt vmcnt(31)
    buffer_load_dwordx4 v1, s[16:19], s42 offen offset:1024 nt lds
    s_mov_b32 m0, s47
    s_waitcnt vmcnt(31)
    buffer_load_dwordx4 v1, s[16:19], s43 offen offset:1024 nt lds
    s_mov_b32 m0, s46
    s_waitcnt vmcnt(31)
    buffer_load_dwordx4 v1, s[16:19], s42 offen offset:2048 nt lds
    s_mov_b32 m0, s47
    s_waitcnt vmcnt(31)
    buffer_load_dwordx4 v1, s[16:19], s43 offen offset:2048 nt lds
    s_mov_b32 m0, s46
    s_waitcnt vmcnt(31)
    buffer_load_dwordx4 v1, s[16:19], s42 offen offset:3072 nt lds
    s_mov_b32 m0, s47
    s_waitcnt vmcnt(31)
    buffer_load_dwordx4 v1, s[16:19], s43 offen offset:3072 nt lds
    s_waitcnt vmcnt(16)
    s_barrier
    s_waitcnt vmcnt(12)
    s_barrier
    s_waitcnt vmcnt(8)
    s_barrier
    s_waitcnt vmcnt(0)
    s_barrier
    s_endpgm
L_lswitch:
    s_add_u32 s16, s8, s32
    s_addc_u32 s17, s9, 0
    s_sub_u32 s40, s40, s18
    s_sub_u32 s41, s41, s18
    s_sub_u32 s42, s42, s18
    s_sub_u32 s43, s43, s18
    s_branch L_lgrp
.p2align 6
L_ctl:
    s_load_dwordx2 s[16:17], s[0:1], 48
    s_mov_b32 s18, 256
    s_mov_b32 s19, 0x20000
    v_and_b32 v0, 63, v0
    v_lshlrev_b32 v1, 12, v0
    s_getreg_b32 s20, hwreg(HW_REG_HW_ID, 8, 7)
    v_lshlrev_b32 v9, 4, v0
    s_lshr_b32 s21, s20, 5
    s_and_b32 s20, s20, 15
    s_lshl_b32 s21, s21, 4
    s_or_b32 s20, s20, s21
    v_mov_b32 v4, 159232
    s_mov_b32 s21, 4
    v_mov_b32 v5, 0
    v_mov_b32 v8, 0
    s_mul_i32 s22, s2, 3072
    s_mov_b32 s26, 3072
    s_mov_b32 s27, 0x20000
    s_mov_b32 m0, 159248
    s_waitcnt lgkmcnt(0)
    s_add_u32 s24, s4, s22
    s_addc_u32 s25, s5, 0
    s_barrier
    buffer_load_dwordx4 v9, s[24:27], 0 offen offset:0 nt lds
    buffer_load_dwordx4 v9, s[24:27], 0 offen offset:1024 nt lds
    buffer_load_dwordx4 v9, s[24:27], 0 offen offset:2048 nt lds
    s_barrier
    s_barrier
    s_waitcnt vmcnt(0)
L_cgrp:
    s_barrier
    s_waitcnt vmcnt(2)
    s_sub_u32 s22, s21, 10
    v_mov_b32 v3, s21
    v_subrev_u32 v6, s22, v5
    v_cmp_ne_u32 s[30:31], 0, v5
    v_cmp_gt_u32 vcc, 16, v6
    v_subrev_u32 v6, 8, v6
    buffer_store_byte v3, v1, s[16:19], s20 offen
    s_and_b64 vcc, vcc, s[30:31]
    buffer_load_ubyte v5, v0, s[16:19], 0 offen sc1
    v_cndmask_b32 v6, 0, v6, vcc
    s_nop 1
    v_add_u32_dpp v6, v6, v6 row_shr:1 row_mask:0xf bank_mask:0xf bound_ctrl:1
    s_nop 1
    v_add_u32_dpp v6, v6, v6 row_shr:2 row_mask:0xf bank_mask:0xf bound_ctrl:1
    s_nop 1
    v_add_u32_dpp v6, v6, v6 row_shr:4 row_mask:0xf bank_mask:0xf bound_ctrl:1
    s_nop 1
    v_add_u32_dpp v6, v6, v6 row_shr:8 row_mask:0xf bank_mask:0xf bound_ctrl:1
    s_add_u32 s21, s21, 1
    v_readlane_b32 s22, v6, 15
    v_readlane_b32 s23, v6, 31
    v_readlane_b32 s28, v6, 47
    v_readlane_b32 s29, v6, 63
    s_add_i32 s22, s22, s23
    s_add_i32 s28, s28, s29
    s_add_i32 s22, s22, s28
    s_add_i32 s22, s22, 16
    s_ashr_i32 s22, s22, 3
    s_add_i32 s22, s22, 21
    s_max_i32 s22, s22, 15
    s_min_i32 s22, s22, 26
    s_cmp_lt_u32 s21, 8
    s_cselect_b32 s22, 21, s22
    s_min_i32 s22, s22, 32
    s_and_b32 s23, s22, 15
    s_lshr_b32 s22, s22, 4
    s_lshl_b32 s22, s22, 22
    s_or_b32 s22, s22, s23
    v_mov_b32 v7, s22
    ds_write_b32 v4, v7
    s_barrier
    s_waitcnt vmcnt(2)
    s_sub_u32 s22, s21, 10
    v_mov_b32 v3, s21
    v_subrev_u32 v6, s22, v8
    v_cmp_ne_u32 s[30:31], 0, v8
    v_cmp_gt_u32 vcc, 16, v6
    v_subrev_u32 v6, 8, v6
    buffer_store_byte v3, v1, s[16:19], s20 offen
    s_and_b64 vcc, vcc, s[30:31]
    buffer_load_ubyte v8, v0, s[16:19], 0 offen sc1
    v_cndmask_b32 v6, 0, v6, vcc
    s_nop 1
    v_add_u32_dpp v6, v6, v6 row_shr:1 row_mask:0xf bank_mask:0xf bound_ctrl:1
    s_nop 1
    v_add_u32_dpp v6, v6, v6 row_shr:2 row_mask:0xf bank_mask:0xf bound_ctrl:1
    s_nop 1
    v_add_u32_dpp v6, v6, v6 row_shr:4 row_mask:0xf bank_mask:0xf bound_ctrl:1
    s_nop 1
    v_add_u32_dpp v6, v6, v6 row_shr:8 row_mask:0xf bank_mask:0xf bound_ctrl:1
    s_add_u32 s21, s21, 1
    v_readlane_b32 s22, v6, 15
    v_readlane_b32 s23, v6, 31
    v_readlane_b32 s28, v6, 47
    v_readlane_b32 s29, v6, 63
    s_add_i32 s22, s22, s23
    s_add_i32 s28, s28, s29
    s_add_i32 s22, s22, s28
    s_add_i32 s22, s22, 16
    s_ashr_i32 s22, s22, 3
    s_add_i32 s22, s22, 21
    s_max_i32 s22, s22, 15
    s_min_i32 s22, s22, 26
    s_cmp_lt_u32 s21, 8
    s_cselect_b32 s22, 21, s22
    s_min_i32 s22, s22, 32
    s_and_b32 s23, s22, 15
    s_lshr_b32 s22, s22, 4
    s_lshl_b32 s22, s22, 22
    s_or_b32 s22, s22, s23
    v_mov_b32 v7, s22
    ds_write_b32 v4, v7
    s_cmp_lt_u32 s21, 92
    s_cbranch_scc1 L_cgrp
    s_endpgm
.p2align 6
L_cons:
    s_cmp_eq_u32 s3, 256
    s_cbranch_scc1 L_ctl
    s_lshr_b32 s33, s3, 6
    s_sub_u32 s33, s33, 1
    v_and_b32 v0, 63, v0
    v_lshlrev_b32 v14, 4, v0
    v_and_b32 v1, 15, v0
    v_lshrrev_b32 v2, 4, v0
    v_mul_u32_u24 v15, 0x180, v1
    s_lshl_b32 s36, s33, 7
    v_lshl_add_u32 v15, v2, 3, v15
    v_add_u32 v15, s36, v15
    v_mul_u32_u24 v12, 0x410, v1
    v_lshl_add_u32 v12, v2, 3, v12
    v_lshrrev_b32 v5, 2, v0
    v_mul_u32_u24 v5, 3, v5
    v_add_u32 v5, s33, v5
    v_bfe_u32 v6, v5, 1, 2
    v_lshlrev_b32 v6, 5, v6
    v_lshl_add_u32 v6, v5, 7, v6
    v_and_b32 v7, 3, v0
    v_lshl_add_u32 v4, v7, 3, v6
    v_xor_b32 v5, 32, v4
    v_xor_b32 v6, 64, v4
    v_xor_b32 v7, 96, v4
    v_add_u32 v3, 156160, v14
    v_lshlrev_b32 v2, 2, v2
    v_sub_u32 v2, v1, v2
    v_mov_b32 v44, 0x3f80
    v_mov_b32 v45, 0x3f800000
    v_mov_b32 v16, 0
    v_mov_b32 v17, 0
    v_cmp_eq_u32 vcc, 0, v2
    s_nop 1
    v_cndmask_b32 v16, v16, v44, vcc
    v_cmp_eq_u32 vcc, 1, v2
    s_nop 1
    v_cndmask_b32 v16, v16, v45, vcc
    v_cmp_eq_u32 vcc, 2, v2
    s_nop 1
    v_cndmask_b32 v17, v17, v44, vcc
    v_cmp_eq_u32 vcc, 3, v2
    s_nop 1
    v_cndmask_b32 v17, v17, v45, vcc
    s_mov_b32 s34, 0
    s_mov_b32 s37, 0
    s_mov_b32 s38, 122880
    s_mov_b32 s39, 139520
    v_mov_b32 v28, 0
    v_mov_b32 v29, 0
    v_mov_b32 v30, 0
    v_mov_b32 v31, 0
    v_mov_b32 v32, 0
    v_mov_b32 v33, 0
    v_mov_b32 v34, 0
    v_mov_b32 v35, 0
    v_mov_b32 v36, 0
    v_mov_b32 v37, 0
    v_mov_b32 v38, 0
    v_mov_b32 v39, 0
    v_mov_b32 v40, 0
    v_mov_b32 v41, 0
    v_mov_b32 v42, 0
    v_mov_b32 v43, 0
    s_mov_b32 s22, 65536
    s_mov_b32 s23, 0x20000
    s_mul_i32 s36, s33, 1040
    s_add_u32 m0, s36, s38
    s_lshl_b32 s45, s33, 12
    s_mul_i32 s32, s2, 3072
    s_mov_b32 s30, 3072
    s_mov_b32 s31, 0x20000
    s_waitcnt lgkmcnt(0)
    s_mov_b32 s20, s10
    s_mov_b32 s21, s11
    s_add_u32 s28, s14, s32
    s_addc_u32 s29, s15, 0
L_e0:
    buffer_load_dwordx4 v14, s[20:23], s45 offen lds
    s_addk_i32 m0, 3120
    s_addk_i32 s45, 12288
    s_cmp_lt_u32 s45, s22
    s_cbranch_scc1 L_e0
L_period:
    s_mov_b32 s42, 0x68542130
    s_mov_b32 s43, 0xfdceba79
    s_mov_b32 s40, 0x13eed
    s_mov_b32 s51, s33
    s_mov_b32 s53, -1
    s_add_u32 s52, s34, 1
    s_and_b32 s52, s52, 3
    s_cbranch_scc1 L_nosw
    s_mov_b32 s20, s12
    s_mov_b32 s21, s13
L_nosw:
    s_lshl_b32 s52, s52, 10
    s_cmp_eq_u32 s34, 7
    s_cselect_b32 s51, 16, s51
    s_cselect_b32 s40, 0x1feed, s40
    s_barrier
    s_cmp_eq_u32 s34, 3
    s_cbranch_scc1 L_qread
    s_cmp_eq_u32 s34, 4
    s_cbranch_scc1 L_epi
    s_cmp_eq_u32 s34, 5
    s_cbranch_scc1 L_softmax
L_q0done:
    s_waitcnt vmcnt(0)
L_block:
    s_and_b32 s45, s42, 15
    s_lshr_b64 s[42:43], s[42:43], 4
    s_lshl_b32 s46, s45, 6
    s_add_u32 s46, s46, s38
    s_mul_i32 s45, s45, 12288
    v_add_u32 v13, s46, v12
    s_add_u32 s45, s45, s37
    s_sub_u32 s36, s45, 122880
    s_cselect_b32 s45, s45, s36
    s_sub_u32 s36, s45, 122880
    s_cselect_b32 s45, s45, s36
    v_add_u32 v8, s45, v4
    v_add_u32 v9, s45, v5
    v_add_u32 v10, s45, v6
    v_add_u32 v11, s45, v7
    s_bitcmp0_b32 s40, 0
    s_cbranch_scc1 L_nobarc
    s_barrier
L_nobarc:
    ds_read_b64 v[60:61], v13
    ds_read_b64 v[62:63], v13 offset:32
    ds_read_b64_tr_b16 v[44:45], v8
    ds_read_b64_tr_b16 v[46:47], v8 offset:6144
    ds_read_b64_tr_b16 v[48:49], v9
    ds_read_b64_tr_b16 v[50:51], v9 offset:6144
    ds_read_b64_tr_b16 v[52:53], v10
    ds_read_b64_tr_b16 v[54:55], v10 offset:6144
    ds_read_b64_tr_b16 v[56:57], v11
    ds_read_b64_tr_b16 v[58:59], v11 offset:6144
    s_add_u32 s53, s53, 1
    s_cmp_lg_u32 s51, s53
    s_cbranch_scc1 L_noe
    s_mul_i32 s36, s51, 1040
    s_add_u32 m0, s36, s39
    s_lshl_b32 s36, s51, 12
    s_add_u32 s36, s36, s52
    s_add_u32 s51, s51, 3
    buffer_load_dwordx4 v14, s[20:23], s36 offen lds
L_noe:
    s_lshr_b32 s40, s40, 1
    s_cmp_lg_u32 s40, 1
    s_waitcnt lgkmcnt(6)
    v_mfma_f32_16x16x32_bf16 v[28:31], v[60:63], v[44:47], v[28:31]
    s_waitcnt lgkmcnt(4)
    v_mfma_f32_16x16x32_bf16 v[32:35], v[60:63], v[48:51], v[32:35]
    s_waitcnt lgkmcnt(2)
    v_mfma_f32_16x16x32_bf16 v[36:39], v[60:63], v[52:55], v[36:39]
    s_waitcnt lgkmcnt(0)
    v_mfma_f32_16x16x32_bf16 v[40:43], v[60:63], v[56:59], v[40:43]
    s_cbranch_scc1 L_block
    s_add_u32 s34, s34, 1
    s_and_b32 s36, s34, 7
    s_cbranch_scc1 L_nextp
L_epi:
    v_cvt_pk_bf16_f32 v44, v28, v29
    v_cvt_pk_bf16_f32 v45, v30, v31
    v_cvt_pk_bf16_f32 v46, v32, v33
    v_cvt_pk_bf16_f32 v47, v34, v35
    v_cvt_pk_bf16_f32 v48, v36, v37
    v_cvt_pk_bf16_f32 v49, v38, v39
    v_cvt_pk_bf16_f32 v50, v40, v41
    v_cvt_pk_bf16_f32 v51, v42, v43
    s_cmp_lg_u32 s34, 8
    v_mfma_f32_16x16x16_bf16 v[28:31], v[44:45], v[16:17], 0
    v_mfma_f32_16x16x16_bf16 v[32:35], v[46:47], v[16:17], 0
    v_mfma_f32_16x16x16_bf16 v[36:39], v[48:49], v[16:17], 0
    v_mfma_f32_16x16x16_bf16 v[40:43], v[50:51], v[16:17], 0
    s_nop 4
    v_cvt_pk_bf16_f32 v52, v28, v29
    v_cvt_pk_bf16_f32 v53, v30, v31
    v_cvt_pk_bf16_f32 v54, v32, v33
    v_cvt_pk_bf16_f32 v55, v34, v35
    v_cvt_pk_bf16_f32 v56, v36, v37
    v_cvt_pk_bf16_f32 v57, v38, v39
    v_cvt_pk_bf16_f32 v58, v40, v41
    v_cvt_pk_bf16_f32 v59, v42, v43
    s_cbranch_scc1 L_kpass
    buffer_store_dwordx2 v[52:53], v15, s[28:31], 0 offen offset:0
    buffer_store_dwordx2 v[54:55], v15, s[28:31], 0 offen offset:32
    buffer_store_dwordx2 v[56:57], v15, s[28:31], 0 offen offset:64
    buffer_store_dwordx2 v[58:59], v15, s[28:31], 0 offen offset:96
    s_endpgm
L_kpass:
    s_nop 0
    v_mfma_f32_16x16x32_bf16 v[60:63], v[52:55], v[20:23], 0
    v_mfma_f32_16x16x32_bf16 v[60:63], v[56:59], v[24:27], v[60:63]
    s_lshl_b32 s36, s33, 10
    v_add_u32 v13, s36, v3
    v_mov_b32 v28, 0
    v_mov_b32 v29, 0
    v_mov_b32 v30, 0
    v_mov_b32 v31, 0
    v_mov_b32 v32, 0
    v_mov_b32 v33, 0
    v_mov_b32 v34, 0
    v_mov_b32 v35, 0
    v_mov_b32 v36, 0
    v_mov_b32 v37, 0
    v_mov_b32 v38, 0
    v_mov_b32 v39, 0
    v_mov_b32 v40, 0
    v_mov_b32 v41, 0
    v_mov_b32 v42, 0
    v_mov_b32 v43, 0
    ds_write_b128 v13, v[60:63]
    s_waitcnt lgkmcnt(0)
    s_branch L_q0done
L_nextp:
    s_add_u32 s37, s37, 73728
    s_sub_u32 s36, s37, 122880
    s_cselect_b32 s37, s37, s36
    s_mov_b32 s36, s38
    s_mov_b32 s38, s39
    s_mov_b32 s39, s36
    s_branch L_period
L_qread:
    v_and_b32 v1, 7, v0
    v_mul_u32_u24 v1, 0x180, v1
    v_lshrrev_b32 v2, 4, v0
    v_lshl_add_u32 v1, v2, 3, v1
    s_lshl_b32 s36, s33, 7
    s_add_u32 s36, s36, 159248
    v_add_u32 v1, s36, v1
    ds_read_b64 v[20:21], v1 offset:0
    ds_read_b64 v[22:23], v1 offset:32
    ds_read_b64 v[24:25], v1 offset:64
    ds_read_b64 v[26:27], v1 offset:96
    s_waitcnt lgkmcnt(0)
    s_branch L_q0done
L_softmax:
    ds_read_b128 v[44:47], v3 offset:0
    ds_read_b128 v[48:51], v3 offset:1024
    ds_read_b128 v[52:55], v3 offset:2048
    s_mov_b32 s47, 0x3d93cd3a
    s_mov_b32 s48, 0x3fb8aa3b
    s_mov_b32 s49, 0xffff0000
    s_waitcnt lgkmcnt(1)
    v_add_f32 v44, v44, v48
    v_add_f32 v45, v45, v49
    v_add_f32 v46, v46, v50
    v_add_f32 v47, v47, v51
    s_waitcnt lgkmcnt(0)
    v_add_f32 v44, v44, v52
    v_add_f32 v45, v45, v53
    v_add_f32 v46, v46, v54
    v_add_f32 v47, v47, v55
    v_cvt_pk_bf16_f32 v56, v44, v45
    v_cvt_pk_bf16_f32 v57, v46, v47
    v_lshlrev_b32 v44, 16, v56
    v_and_b32 v45, s49, v56
    v_lshlrev_b32 v46, 16, v57
    v_and_b32 v47, s49, v57
    v_mul_f32 v44, s47, v44
    v_mul_f32 v45, s47, v45
    v_mul_f32 v46, s47, v46
    v_mul_f32 v47, s47, v47
    v_cvt_pk_bf16_f32 v56, v44, v45
    v_cvt_pk_bf16_f32 v57, v46, v47
    v_lshlrev_b32 v44, 16, v56
    v_and_b32 v45, s49, v56
    v_lshlrev_b32 v46, 16, v57
    v_and_b32 v47, s49, v57
    v_max3_f32 v56, v44, v45, v46
    v_max_f32 v56, v56, v47
    v_mov_b32 v57, v56
    s_nop 1
    v_permlane16_swap_b32 v56, v57
    s_nop 1
    v_max_f32 v56, v56, v57
    v_mov_b32 v57, v56
    s_nop 1
    v_permlane32_swap_b32 v56, v57
    s_nop 1
    v_max_f32 v56, v56, v57
    v_sub_f32 v44, v44, v56
    v_sub_f32 v45, v45, v56
    v_sub_f32 v46, v46, v56
    v_sub_f32 v47, v47, v56
    v_mul_f32 v44, s48, v44
    v_mul_f32 v45, s48, v45
    v_mul_f32 v46, s48, v46
    v_mul_f32 v47, s48, v47
    v_exp_f32 v44, v44
    v_exp_f32 v45, v45
    v_exp_f32 v46, v46
    v_exp_f32 v47, v47
    s_nop 0
    v_add_f32 v56, v44, v45
    v_add_f32 v58, v46, v47
    v_add_f32 v56, v56, v58
    v_mov_b32 v57, v56
    s_nop 1
    v_permlane16_swap_b32 v56, v57
    s_nop 1
    v_add_f32 v56, v56, v57
    v_mov_b32 v57, v56
    s_nop 1
    v_permlane32_swap_b32 v56, v57
    s_nop 1
    v_add_f32 v56, v56, v57
    v_rcp_f32 v56, v56
    s_nop 0
    v_mul_f32 v44, v44, v56
    v_mul_f32 v45, v45, v56
    v_mul_f32 v46, v46, v56
    v_mul_f32 v47, v47, v56
    v_cvt_pk_bf16_f32 v16, v44, v45
    v_cvt_pk_bf16_f32 v17, v46, v47
    s_branch L_q0done
L_fin:
L_end:
    s_endpgm
.section .rodata,"a"
.p2align 6
.amdhsa_kernel standalone__low_rank_proj_linformer__sampling_kernel
  .amdhsa_next_free_vgpr 64
  .amdhsa_next_free_sgpr 56
  .amdhsa_accum_offset 64
  .amdhsa_group_segment_fixed_size 0
  .amdhsa_kernarg_size 64
  .amdhsa_user_sgpr_count 2
  .amdhsa_user_sgpr_kernarg_segment_ptr 1
  .amdhsa_system_sgpr_workgroup_id_x 1
  .amdhsa_float_denorm_mode_32 3
.end_amdhsa_kernel
```
